```python
import torch

def _softmax(x, axis=-1):
    return torch.softmax(x, dim=axis)
def _gelu(x):
    return torch.nn.functional.gelu(x, approximate="tanh")
def _silu(x):
    return torch.nn.functional.silu(x)
def _sigmoid(x):
    return torch.sigmoid(x)
def _layernorm(x, axis=-1, eps=1e-5):
    m = x.mean(dim=axis, keepdim=True)
    v = x.var(dim=axis, keepdim=True, unbiased=False)
    return (x - m) / torch.sqrt(v + eps)
def _scatter_add(tgt, idx, src, axis=0):
    return tgt.clone().index_add_(axis, idx, src)
def _segment_sum(src, seg, n):
    out = torch.zeros((n,) + src.shape[1:], dtype=src.dtype)
    return out.index_add_(0, seg, src)
def _pad(x, pw):
    flat = tuple(v for pair in reversed(pw) for v in pair)
    return torch.nn.functional.pad(x, flat)

kernel_name = 'gated_mix__sliding_block_cached__dense_activation_gelu__decode'

def setup_inputs():

    _w = (lambda a: (lambda t: t.to(torch.bfloat16) if t.is_floating_point() else t)(torch.as_tensor(a)))
    def _A_setup():
        B, Sq, D = 1, 1, 640
        Hq, Hkv, Sk, Dh = 32, 32, 32768, 192
        assert Hq % Hkv == 0, (Hq, Hkv)
        return {
            "x": _w((lambda *s: torch.randn(*s, dtype=torch.bfloat16) * 0.05)(B, Sq, D)),
            "k_cache": _w((lambda *s: torch.randn(*s, dtype=torch.bfloat16) * 6.4)(B, Hkv, Sk, Dh)),
            "v_cache": _w((lambda *s: torch.randn(*s, dtype=torch.bfloat16) * 0.2)(B, Hkv, Sk, Dh)),
            "wq": _w((lambda *s: torch.randn(*s, dtype=torch.bfloat16) * 6.4)(D, Hq * Dh) * (D ** -0.5)),
            "wo": _w((lambda *s: torch.randn(*s, dtype=torch.bfloat16) * 0.2)(Hq * Dh, D) * ((Hq * Dh) ** -0.5)),
        }
    _A_in = _A_setup()

    def _B_setup():
        B, S, D, F = 1, 1, 640, 1536
        return {
            "x": _w((lambda *s: torch.randn(*s, dtype=torch.bfloat16) * 0.05)(B, S, D)),
            "w1": _w((lambda *s: torch.randn(*s, dtype=torch.bfloat16) * 3.2)(D, F) * (D ** -0.5)),
            "b1": _w((lambda *s: torch.randn(*s, dtype=torch.bfloat16) * 3.2)(F) * 0.01),
            "w2": _w((lambda *s: torch.randn(*s, dtype=torch.bfloat16) * 0.05)(F, D) * (F ** -0.5)),
            "b2": _w((lambda *s: torch.randn(*s, dtype=torch.bfloat16) * 0.05)(D) * 0.01),
        }
    _B_in = _B_setup()

    return {
        "A_x": _A_in["x"],
        "A_k_cache": _A_in["k_cache"],
        "A_v_cache": _A_in["v_cache"],
        "A_wq": _A_in["wq"],
        "A_wo": _A_in["wo"],
        "B_x": _B_in["x"],
        "B_w1": _B_in["w1"],
        "B_b1": _B_in["b1"],
        "B_w2": _B_in["w2"],
        "B_b2": _B_in["b2"],
        "gate_w": _w((lambda *s: torch.randn(*s, dtype=torch.bfloat16) * 0.05)(640) * 16.0),
    }

def reference(A_x, A_k_cache, A_v_cache, A_wq, A_wo, B_x, B_w1, B_b1, B_w2, B_b2, gate_w):
    def _A_ref(x, k_cache, v_cache, wq, wo):
        B, Sq, D = x.shape
        Hq, Dh = 32, 192
        Hkv, Sk = k_cache.shape[1], k_cache.shape[2]
        W = min(4096, max(256, Sk // 4))
        rep = Hq // Hkv
        q = (lambda x, *d: x.permute(*d))((x @ wq).reshape(B, Sq, Hq, Dh), 0, 2, 1, 3)
        k = (lambda x, n, axis: torch.repeat_interleave(x, n, dim=axis))(k_cache[:, :, Sk - W:, :], rep, axis=1)
        v = (lambda x, n, axis: torch.repeat_interleave(x, n, dim=axis))(v_cache[:, :, Sk - W:, :], rep, axis=1)
        scores = torch.einsum("bhqd,bhkd->bhqk", q, k) * (Dh ** -0.5)
        p = _softmax(scores, axis=-1)
        o = torch.einsum("bhqk,bhkd->bhqd", p, v)
        return (lambda x, *d: x.permute(*d))(o, 0, 2, 1, 3).reshape(B, Sq, Hq * Dh) @ wo

    def _B_ref(x, w1, b1, w2, b2):
        h = torch.einsum("bsd,df->bsf", x, w1) + b1
        h = _gelu(h)
        return torch.einsum("bsf,fd->bsd", h, w2) + b2

    x = A_x
    g = _sigmoid((x * gate_w).sum(-1, keepdims=True))
    a = _A_ref(x, A_k_cache, A_v_cache, A_wq, A_wo)
    b = _B_ref(x, B_w1, B_b1, B_w2, B_b2)
    return g * a + (1 - g) * b
```

```asm
; @launch grid=(256,1,1) block=(768,1,1) lds=20352
.amdgcn_target "amdgcn-amd-amdhsa--gfx950"
.text
.p2align 12
.globl gated_mix__sliding_block_cached__dense_activation_gelu__decode_kernel
.p2align 8
.type gated_mix__sliding_block_cached__dense_activation_gelu__decode_kernel,@function
gated_mix__sliding_block_cached__dense_activation_gelu__decode_kernel:
    s_load_dwordx16 s[4:19], s[0:1], 0
    s_load_dwordx8 s[20:27], s[0:1], 64
    s_load_dwordx2 s[30:31], s[0:1], 104
    s_cmp_ge_u32 s2, 256
    s_cbranch_scc1 L_end
    v_lshrrev_b32 v2, 6, v0
    v_and_b32 v1, 63, v0
    v_readfirstlane_b32 s72, v2
    s_and_b32 s73, s2, 31
    s_lshr_b32 s74, s2, 5
    s_and_b32 s68, s2, 7
    s_and_b32 s69, s2, 24
    s_add_u32 s69, s69, s74
    v_and_b32 v52, 15, v1
    v_lshrrev_b32 v53, 4, v1
    v_lshlrev_b32 v9, 4, v52
    s_cmp_lt_u32 s72, 4
    s_cbranch_scc0 L_stream
    s_mul_i32 s3, s74, 80
    s_mul_i32 s100, s72, 28
    s_add_u32 s3, s3, s100
    s_mul_i32 s100, s69, 20
    s_cmp_eq_u32 s72, 2
    s_cselect_b32 s101, 24, 28
    s_cmp_lt_u32 s72, 3
    s_cselect_b32 s3, s3, s100
    s_cselect_b32 s101, s101, 20
    s_cselect_b32 s100, s73, s68
    s_movk_i32 s75, 3072
    s_cselect_b32 s75, 12288, s75
    s_mul_i32 s100, s100, 384
    s_mul_i32 s54, s101, s75
    s_mul_i32 s101, s3, s75
    s_add_u32 s101, s101, s100
    s_mov_b32 s55, 0x20000
    v_lshlrev_b32 v2, 1, v53
    v_mad_u32_u24 v133, v2, s75, v9
    s_sub_u32 s100, s75, 384
    v_lshrrev_b32 v2, 3, v52
    v_mad_u32_u24 v134, v2, s100, v133
    v_lshrrev_b32 v2, 3, v1
    v_add_lshl_u32 v3, v2, s3, 1
    v_lshlrev_b32 v2, 3, v0
    v_mov_b32 v12, 0
    v_mov_b32 v13, 0
    ds_write_b64 v2, v[12:13]
    s_mul_i32 s34, s75, 8
    s_mul_i32 s35, s75, 9
    s_mul_i32 s36, s75, 16
    s_mul_i32 s37, s75, 17
    s_mul_i32 s38, s75, 24
    s_mul_i32 s39, s75, 25
    s_movk_i32 s58, 1280
    s_mov_b32 s59, 0x20000
    s_movk_i32 s62, 1280
    s_mov_b32 s63, 0x20000
    s_cmp_lt_u32 s72, 3
    s_waitcnt lgkmcnt(0)
    s_cselect_b32 s52, s10, s16
    s_cselect_b32 s53, s11, s17
    s_add_u32 s52, s52, s101
    s_addc_u32 s53, s53, 0
    buffer_load_dwordx4 v[60:63], v133, s[52:55], 0 offen nt
    buffer_load_dwordx4 v[64:67], v134, s[52:55], 0 offen offset:256 nt
    buffer_load_dwordx4 v[68:71], v133, s[52:55], s75 offen offset:128 nt
    buffer_load_dwordx4 v[72:75], v133, s[52:55], s34 offen nt
    buffer_load_dwordx4 v[76:79], v134, s[52:55], s34 offen offset:256 nt
    buffer_load_dwordx4 v[80:83], v133, s[52:55], s35 offen offset:128 nt
    buffer_load_dwordx4 v[84:87], v133, s[52:55], s36 offen nt
    buffer_load_dwordx4 v[88:91], v134, s[52:55], s36 offen offset:256 nt
    buffer_load_dwordx4 v[92:95], v133, s[52:55], s37 offen offset:128 nt
    buffer_load_dwordx4 v[96:99], v133, s[52:55], s38 offen nt
    buffer_load_dwordx4 v[100:103], v134, s[52:55], s38 offen offset:256 nt
    buffer_load_dwordx4 v[104:107], v133, s[52:55], s39 offen offset:128 nt
    s_mov_b32 s56, s4
    s_mov_b32 s57, s5
    s_mov_b32 s60, s24
    s_mov_b32 s61, s25
    buffer_load_ushort v124, v3, s[56:59], 0 offen offset:0
    buffer_load_ushort v125, v3, s[56:59], 0 offen offset:16
    buffer_load_ushort v126, v3, s[56:59], 0 offen offset:32
    buffer_load_ushort v127, v3, s[56:59], 0 offen offset:48
    buffer_load_dwordx2 v[128:129], v2, s[56:59], 0 offen
    buffer_load_dwordx2 v[130:131], v2, s[60:63], 0 offen
    s_load_dword s14, s[30:31], 0
    s_barrier
    s_branch L_service
L_stream:
    s_cmp_eq_u32 s72, 11
    s_cbranch_scc1 L_wp0
    s_cmp_eq_u32 s72, 10
    s_cbranch_scc1 L_wp1
    s_cmp_eq_u32 s72, 9
    s_cbranch_scc1 L_wp2
    s_cmp_eq_u32 s72, 8
    s_cbranch_scc1 L_wp3
    s_cmp_eq_u32 s72, 7
    s_cbranch_scc1 L_wp4
    s_cmp_eq_u32 s72, 6
    s_cbranch_scc1 L_wp5
L_back:
    s_sub_u32 s70, s72, 4
    s_mul_i32 s3, s73, 12582912
    s_mul_i32 s100, s70, 12288
    s_add_u32 s3, s3, s100
    s_mul_i32 s100, s74, 1536
    s_add_u32 s3, s3, s100
    s_add_u32 s3, s3, 11010048
    s_mov_b32 s34, 1476096
    s_mov_b32 s35, 0x20000
    s_mov_b32 s38, s34
    s_mov_b32 s39, 0x20000
    v_and_b32 v2, 3, v1
    v_lshlrev_b32 v8, 4, v2
    v_lshl_add_u32 v8, v53, 6, v8
    v_lshrrev_b32 v2, 2, v52
    v_mul_u32_u24 v2, 768, v2
    v_add_u32 v8, v8, v2
    v_mul_u32_u24 v2, 768, v53
    v_add_u32 v9, v9, v2
    v_lshrrev_b32 v2, 3, v52
    v_mul_u32_u24 v2, 96768, v2
    v_add_u32 v8, v8, v2
    v_lshrrev_b32 v2, 5, v1
    v_mul_u32_u24 v2, 96768, v2
    v_add_u32 v9, v9, v2
    s_lshr_b32 s100, s73, 3
    s_lshl_b32 s100, s100, 1
    s_add_u32 s52, s100, 0
    s_and_b32 s52, s52, 7
    s_mul_i32 s52, s52, 196608
    s_add_u32 s53, s100, 1
    s_and_b32 s53, s53, 7
    s_mul_i32 s53, s53, 196608
    s_add_u32 s54, s100, 2
    s_and_b32 s54, s54, 7
    s_mul_i32 s54, s54, 196608
    s_add_u32 s55, s100, 3
    s_and_b32 s55, s55, 7
    s_mul_i32 s55, s55, 196608
    s_add_u32 s56, s100, 4
    s_and_b32 s56, s56, 7
    s_mul_i32 s56, s56, 196608
    s_add_u32 s57, s100, 5
    s_and_b32 s57, s57, 7
    s_mul_i32 s57, s57, 196608
    s_add_u32 s58, s100, 6
    s_and_b32 s58, s58, 7
    s_mul_i32 s58, s58, 196608
    s_add_u32 s59, s100, 7
    s_and_b32 s59, s59, 7
    s_mul_i32 s59, s59, 196608
    s_waitcnt lgkmcnt(0)
    s_add_u32 s32, s6, s3
    s_addc_u32 s33, s7, 0
    s_barrier
    buffer_load_dwordx4 v[60:63], v8, s[32:35], s52 offen offset:0 nt
    buffer_load_dwordx4 v[64:67], v8, s[32:35], s52 offen offset:256 nt
    buffer_load_dwordx4 v[68:71], v8, s[32:35], s52 offen offset:512 nt
    s_add_u32 s36, s8, s3
    s_addc_u32 s37, s9, 0
    s_load_dword s14, s[30:31], 0
    v_and_b32 v2, 1, v1
    v_lshlrev_b32 v2, 4, v2
    v_mov_b32 v3, 0xffff
    v_lshlrev_b32 v2, v2, v3
    v_bfe_u32 v3, v1, 1, 2
    v_cmp_eq_u32 vcc, 0, v3
    s_nop 1
    v_cndmask_b32 v4, 0, v2, vcc
    v_cmp_eq_u32 vcc, 1, v3
    s_nop 1
    v_cndmask_b32 v5, 0, v2, vcc
    v_cmp_eq_u32 vcc, 2, v3
    s_nop 1
    v_cndmask_b32 v6, 0, v2, vcc
    v_cmp_eq_u32 vcc, 3, v3
    s_nop 1
    v_cndmask_b32 v7, 0, v2, vcc
    s_mul_i32 s3, s70, 1536
    s_add_u32 s3, s3, 1792
    v_and_b32 v2, 16, v1
    v_lshl_add_u32 v55, v52, 5, v2
    v_add_u32 v10, s3, v55
    v_mov_b32 v3, 1152
    v_mov_b32 v0, 1
    s_mov_b32 s48, s30
    s_mov_b32 s49, s31
    s_mov_b32 s50, 548864
    s_mov_b32 s51, 0x20000
    s_mul_i32 s28, s69, 52
    s_lshr_b32 s28, s28, 8
    s_mul_i32 s29, s28, 5
    s_sub_u32 s29, s69, s29
    s_min_u32 s28, s28, 5
    v_mov_b32 v11, 0xff
    s_lshl_b32 s3, s28, 3
    s_add_u32 s3, s3, s70
    s_mul_i32 s100, s3, 43
    s_lshr_b32 s100, s100, 9
    s_mul_i32 s101, s100, 12
    s_sub_u32 s101, s3, s101
    s_lshl_b32 s100, s100, 3
    s_add_u32 s100, s100, s68
    s_lshl_b32 s9, s100, 13
    s_lshl_b32 s10, s101, 6
    s_add_u32 s9, s9, s10
    s_add_u32 s9, s9, 266240
    s_mul_i32 s100, s100, 12
    s_add_u32 s100, s100, s101
    s_mul_i32 s100, s100, 20480
    s_lshl_b32 s101, s29, 8
    s_add_u32 s100, s100, s101
    s_add_u32 s40, s12, s100
    s_addc_u32 s41, s13, 0
    s_mul_i32 s100, s68, 48
    s_add_u32 s100, s100, s3
    s_mul_i32 s100, s100, 5120
    s_add_u32 s100, s100, s101
    s_add_u32 s44, s20, s100
    s_addc_u32 s45, s21, 0
    s_cmp_lt_u32 s69, 30
    s_cselect_b32 s42, 19456, 0
    s_cselect_b32 s46, 4096, 0
    s_mov_b32 s43, 0x20000
    s_mov_b32 s47, 0x20000
    s_mov_b32 s71, 0x3fb8aa3b
    s_waitcnt vmcnt(2)
    buffer_load_dwordx4 v[72:75], v8, s[32:35], s53 offen offset:0 nt
    s_waitcnt vmcnt(2)
    buffer_load_dwordx4 v[76:79], v8, s[32:35], s53 offen offset:256 nt
    s_waitcnt vmcnt(2)
    buffer_load_dwordx4 v[80:83], v8, s[32:35], s53 offen offset:512 nt
    v_lshrrev_b32 v2, 3, v1
    v_and_b32 v52, 3, v1
    v_lshlrev_b32 v52, 4, v52
    v_lshl_add_u32 v58, v2, 10, v52
    v_lshl_add_u32 v54, v2, 2, v3
    v_and_b32 v52, 7, v1
    v_lshlrev_b32 v52, 4, v52
    s_lshl_b32 s3, s70, 7
    s_add_u32 s3, s3, 14080
    v_lshl_add_u32 v57, v2, 9, v52
    v_add_u32 v57, s3, v57
    v_mul_u32_u24 v2, 1536, v2
    s_mul_i32 s100, s70, 96
    s_add_u32 s3, s100, 1792
    v_add3_u32 v56, v2, v52, s3
    s_lshl_b32 s3, s70, 9
    s_add_u32 s3, s3, 14080
    v_add_u32 v55, s3, v55
    v_lshlrev_b32 v59, 3, v53
    v_lshl_add_u32 v53, v53, 2, v52
    s_lshl_b32 s3, s73, 3
    s_add_u32 s3, s3, s74
    s_lshl_b32 s3, s3, 10
    s_add_u32 s100, s100, s3
    s_add_u32 s100, s100, 266240
    s_lshl_b32 s12, s29, 2
    s_add_u32 s12, s12, s70
    s_lshl_b32 s19, s12, 6
    s_lshl_b32 s12, s12, 10
    s_add_u32 s12, s12, 528384
    s_mov_b32 s64, s26
    s_mov_b32 s65, s27
    s_movk_i32 s66, 1280
    s_mov_b32 s67, 0x20000
    s_mov_b32 s60, 0x01000100
    s_mov_b32 s61, 0x01000100
    s_movk_i32 s13, 5120
    s_movk_i32 s16, 10240
    s_movk_i32 s17, 15360
    s_waitcnt lgkmcnt(0)
    s_mul_i32 s15, s14, 0x9e3779b1
    s_add_u32 s15, s15, 0x7f4a7c15
    s_or_b32 s15, s15, 0x01010101
    s_xor_b32 s15, s15, s14
    s_xor_b32 s76, s15, 0x02020202
    s_lshr_b32 s77, s76, 8
    s_lshr_b32 s78, s76, 16
    s_lshr_b32 s79, s76, 24
    v_lshrrev_b32_e64 v59, v59, s76
    s_and_b32 s76, s76, 0xff
    s_and_b32 s77, s77, 0xff
    s_and_b32 s78, s78, 0xff
    s_waitcnt vmcnt(2)
    buffer_load_dwordx4 v[84:87], v8, s[32:35], s54 offen offset:0 nt
    s_waitcnt vmcnt(2)
    buffer_load_dwordx4 v[88:91], v8, s[32:35], s54 offen offset:256 nt
    s_waitcnt vmcnt(2)
    buffer_load_dwordx4 v[92:95], v8, s[32:35], s54 offen offset:512 nt
    s_waitcnt vmcnt(2)
    buffer_load_dwordx4 v[96:99], v8, s[32:35], s55 offen offset:0 nt
    s_waitcnt vmcnt(2)
    buffer_load_dwordx4 v[100:103], v8, s[32:35], s55 offen offset:256 nt
    s_waitcnt vmcnt(2)
    buffer_load_dwordx4 v[104:107], v8, s[32:35], s55 offen offset:512 nt
    s_waitcnt vmcnt(3)
    buffer_load_dwordx4 v[108:111], v8, s[32:35], s56 offen offset:0 nt
    s_waitcnt vmcnt(3)
    buffer_load_dwordx4 v[112:115], v8, s[32:35], s56 offen offset:256 nt
    s_cmp_lg_u32 s70, 7
    s_cbranch_scc1 L_sg1192
    s_mov_b64 exec, 1
    ds_add_u32 v3, v0 offset:40
    s_mov_b64 exec, -1
L_sg1192:
    s_waitcnt vmcnt(3)
    buffer_load_dwordx4 v[116:119], v8, s[32:35], s56 offen offset:512 nt
    s_waitcnt vmcnt(2)
    buffer_load_dwordx4 v[120:123], v8, s[32:35], s57 offen offset:0 nt
    s_waitcnt vmcnt(2)
    buffer_load_dwordx4 v[124:127], v8, s[32:35], s57 offen offset:256 nt
    s_waitcnt vmcnt(2)
    buffer_load_dwordx4 v[128:131], v8, s[32:35], s57 offen offset:512 nt
    s_waitcnt vmcnt(2)
    buffer_load_dwordx4 v[132:135], v8, s[32:35], s58 offen offset:0 nt
    s_waitcnt vmcnt(2)
    buffer_load_dwordx4 v[136:139], v8, s[32:35], s58 offen offset:256 nt
    s_waitcnt vmcnt(2)
    buffer_load_dwordx4 v[140:143], v8, s[32:35], s58 offen offset:512 nt
    s_waitcnt vmcnt(2)
    buffer_load_dwordx4 v[144:147], v8, s[32:35], s59 offen offset:0 nt
    s_waitcnt vmcnt(2)
    buffer_load_dwordx4 v[148:151], v8, s[32:35], s59 offen offset:256 nt
    s_waitcnt vmcnt(2)
    buffer_load_dwordx4 v[152:155], v8, s[32:35], s59 offen offset:512 nt
    s_waitcnt vmcnt(2)
    buffer_load_dwordx4 v[156:159], v9, s[36:39], s52 offen offset:0 nt
    s_waitcnt vmcnt(2)
    buffer_load_dwordx4 v[160:163], v9, s[36:39], s52 offen offset:256 nt
    s_waitcnt vmcnt(2)
    buffer_load_dwordx4 v[164:167], v9, s[36:39], s52 offen offset:512 nt
    v_and_b32 v2, 0xf0, v8
    v_bfe_u32 v52, v1, 3, 1
    v_mul_u32_u24 v52, 384, v52
    v_sub_u32 v2, v2, v52
    v_add_u32 v2, 384, v2
    s_mov_b32 s8, 0x400000
L_qw:
    ds_read_b32 v52, v3 offset:36
    ds_read_b128 v[16:19], v2
    ds_read_b128 v[20:23], v2 offset:256
    ds_read_b128 v[24:27], v2 offset:512
    s_waitcnt lgkmcnt(0)
    v_cmp_gt_u32 vcc, 256, v52
    s_cbranch_vccz L_qw_x
    s_sub_u32 s8, s8, 1
    s_cbranch_scc0 L_qw
L_qw_x:
    v_mfma_f32_16x16x32_bf16 v[48:51], v[60:63], v[16:19], 0
    v_mfma_f32_16x16x32_bf16 v[48:51], v[64:67], v[20:23], v[48:51]
    v_mfma_f32_16x16x32_bf16 v[48:51], v[68:71], v[24:27], v[48:51]
    v_mfma_f32_16x16x32_bf16 v[60:63], v[72:75], v[16:19], 0
    v_mfma_f32_16x16x32_bf16 v[60:63], v[76:79], v[20:23], v[60:63]
    v_mfma_f32_16x16x32_bf16 v[60:63], v[80:83], v[24:27], v[60:63]
    v_mfma_f32_16x16x32_bf16 v[72:75], v[84:87], v[16:19], 0
    v_mfma_f32_16x16x32_bf16 v[72:75], v[88:91], v[20:23], v[72:75]
    v_mfma_f32_16x16x32_bf16 v[72:75], v[92:95], v[24:27], v[72:75]
    v_mfma_f32_16x16x32_bf16 v[84:87], v[96:99], v[16:19], 0
    v_mfma_f32_16x16x32_bf16 v[84:87], v[100:103], v[20:23], v[84:87]
    v_mfma_f32_16x16x32_bf16 v[84:87], v[104:107], v[24:27], v[84:87]
    v_mfma_f32_16x16x32_bf16 v[96:99], v[108:111], v[16:19], 0
    v_mfma_f32_16x16x32_bf16 v[96:99], v[112:115], v[20:23], v[96:99]
    v_mfma_f32_16x16x32_bf16 v[96:99], v[116:119], v[24:27], v[96:99]
    v_mfma_f32_16x16x32_bf16 v[108:111], v[120:123], v[16:19], 0
    v_mfma_f32_16x16x32_bf16 v[108:111], v[124:127], v[20:23], v[108:111]
    v_mfma_f32_16x16x32_bf16 v[108:111], v[128:131], v[24:27], v[108:111]
    s_nop 6
    v_mov_b32_dpp v40, v48 quad_perm:[0,0,0,0] row_mask:0xf bank_mask:0xf
    v_mov_b32_dpp v41, v60 quad_perm:[0,0,0,0] row_mask:0xf bank_mask:0xf
    v_mov_b32_dpp v42, v72 quad_perm:[0,0,0,0] row_mask:0xf bank_mask:0xf
    v_mov_b32_dpp v43, v84 quad_perm:[0,0,0,0] row_mask:0xf bank_mask:0xf
    v_mov_b32_dpp v44, v96 quad_perm:[0,0,0,0] row_mask:0xf bank_mask:0xf
    v_mov_b32_dpp v45, v108 quad_perm:[0,0,0,0] row_mask:0xf bank_mask:0xf
    v_add_f32_dpp v40, v49, v40 quad_perm:[1,1,1,1] row_mask:0xf bank_mask:0xf
    v_add_f32_dpp v41, v61, v41 quad_perm:[1,1,1,1] row_mask:0xf bank_mask:0xf
    v_add_f32_dpp v42, v73, v42 quad_perm:[1,1,1,1] row_mask:0xf bank_mask:0xf
    v_add_f32_dpp v43, v85, v43 quad_perm:[1,1,1,1] row_mask:0xf bank_mask:0xf
    v_add_f32_dpp v44, v97, v44 quad_perm:[1,1,1,1] row_mask:0xf bank_mask:0xf
    v_add_f32_dpp v45, v109, v45 quad_perm:[1,1,1,1] row_mask:0xf bank_mask:0xf
    v_add_f32_dpp v40, v50, v40 quad_perm:[2,2,2,2] row_mask:0xf bank_mask:0xf
    v_add_f32_dpp v41, v62, v41 quad_perm:[2,2,2,2] row_mask:0xf bank_mask:0xf
    v_add_f32_dpp v42, v74, v42 quad_perm:[2,2,2,2] row_mask:0xf bank_mask:0xf
    v_add_f32_dpp v43, v86, v43 quad_perm:[2,2,2,2] row_mask:0xf bank_mask:0xf
    v_add_f32_dpp v44, v98, v44 quad_perm:[2,2,2,2] row_mask:0xf bank_mask:0xf
    v_add_f32_dpp v45, v110, v45 quad_perm:[2,2,2,2] row_mask:0xf bank_mask:0xf
    v_add_f32_dpp v40, v51, v40 quad_perm:[3,3,3,3] row_mask:0xf bank_mask:0xf
    v_add_f32_dpp v41, v63, v41 quad_perm:[3,3,3,3] row_mask:0xf bank_mask:0xf
    v_add_f32_dpp v42, v75, v42 quad_perm:[3,3,3,3] row_mask:0xf bank_mask:0xf
    v_add_f32_dpp v43, v87, v43 quad_perm:[3,3,3,3] row_mask:0xf bank_mask:0xf
    v_add_f32_dpp v44, v99, v44 quad_perm:[3,3,3,3] row_mask:0xf bank_mask:0xf
    v_add_f32_dpp v45, v111, v45 quad_perm:[3,3,3,3] row_mask:0xf bank_mask:0xf
    v_cvt_pk_bf16_f32 v40, 0, v40
    v_cvt_pk_bf16_f32 v41, 0, v41
    v_cvt_pk_bf16_f32 v42, 0, v42
    v_cvt_pk_bf16_f32 v43, 0, v43
    v_cvt_pk_bf16_f32 v44, 0, v44
    v_cvt_pk_bf16_f32 v45, 0, v45
    v_mul_f32 v40, 0x3d93cd3a, v40
    v_mul_f32 v41, 0x3d93cd3a, v41
    v_mul_f32 v42, 0x3d93cd3a, v42
    v_mul_f32 v43, 0x3d93cd3a, v43
    v_mul_f32 v44, 0x3d93cd3a, v44
    v_mul_f32 v45, 0x3d93cd3a, v45
    v_cvt_pk_bf16_f32 v40, 0, v40
    v_cvt_pk_bf16_f32 v41, 0, v41
    v_cvt_pk_bf16_f32 v42, 0, v42
    v_cvt_pk_bf16_f32 v43, 0, v43
    v_cvt_pk_bf16_f32 v44, 0, v44
    v_cvt_pk_bf16_f32 v45, 0, v45
    s_waitcnt vmcnt(2)
    buffer_load_dwordx4 v[60:63], v9, s[36:39], s53 offen offset:0 nt
    v_mfma_f32_16x16x32_bf16 v[120:123], v[132:135], v[16:19], 0
    v_mfma_f32_16x16x32_bf16 v[120:123], v[136:139], v[20:23], v[120:123]
    v_mfma_f32_16x16x32_bf16 v[120:123], v[140:143], v[24:27], v[120:123]
    v_mfma_f32_16x16x32_bf16 v[132:135], v[144:147], v[16:19], 0
    v_mfma_f32_16x16x32_bf16 v[132:135], v[148:151], v[20:23], v[132:135]
    v_mfma_f32_16x16x32_bf16 v[132:135], v[152:155], v[24:27], v[132:135]
    s_nop 6
    v_mov_b32_dpp v46, v120 quad_perm:[0,0,0,0] row_mask:0xf bank_mask:0xf
    v_mov_b32_dpp v47, v132 quad_perm:[0,0,0,0] row_mask:0xf bank_mask:0xf
    s_nop 0
    v_add_f32_dpp v46, v121, v46 quad_perm:[1,1,1,1] row_mask:0xf bank_mask:0xf
    v_add_f32_dpp v47, v133, v47 quad_perm:[1,1,1,1] row_mask:0xf bank_mask:0xf
    s_nop 0
    v_add_f32_dpp v46, v122, v46 quad_perm:[2,2,2,2] row_mask:0xf bank_mask:0xf
    v_add_f32_dpp v47, v134, v47 quad_perm:[2,2,2,2] row_mask:0xf bank_mask:0xf
    s_nop 0
    v_add_f32_dpp v46, v123, v46 quad_perm:[3,3,3,3] row_mask:0xf bank_mask:0xf
    v_add_f32_dpp v47, v135, v47 quad_perm:[3,3,3,3] row_mask:0xf bank_mask:0xf
    v_cvt_pk_bf16_f32 v46, 0, v46
    v_cvt_pk_bf16_f32 v47, 0, v47
    v_mul_f32 v46, 0x3d93cd3a, v46
    v_mul_f32 v47, 0x3d93cd3a, v47
    v_cvt_pk_bf16_f32 v46, 0, v46
    v_cvt_pk_bf16_f32 v47, 0, v47
    s_waitcnt vmcnt(2)
    buffer_load_dwordx4 v[64:67], v9, s[36:39], s53 offen offset:256 nt
    v_max3_f32 v2, v40, v41, v42
    v_max3_f32 v2, v2, v43, v44
    v_max3_f32 v2, v2, v45, v46
    v_max_f32 v2, v2, v47
    s_nop 1
    v_max_f32_dpp v12, v2, v2 row_ror:8 row_mask:0xf bank_mask:0xf
    v_max_f32_dpp v52, v2, v2 row_ror:8 row_mask:0xf bank_mask:0xf
    s_nop 1
    v_permlane16_swap_b32 v12, v52
    v_max_f32 v12, v12, v52
    v_mov_b32 v52, v12
    s_nop 1
    v_permlane32_swap_b32 v12, v52
    v_max_f32 v12, v12, v52
    v_mul_f32 v12, s71, v12
    v_fma_f32 v40, v40, s71, -v12
    v_fma_f32 v41, v41, s71, -v12
    v_fma_f32 v42, v42, s71, -v12
    v_fma_f32 v43, v43, s71, -v12
    v_fma_f32 v44, v44, s71, -v12
    v_fma_f32 v45, v45, s71, -v12
    v_fma_f32 v46, v46, s71, -v12
    v_fma_f32 v47, v47, s71, -v12
    v_exp_f32 v40, v40
    v_exp_f32 v41, v41
    v_exp_f32 v42, v42
    v_exp_f32 v43, v43
    v_exp_f32 v44, v44
    v_exp_f32 v45, v45
    v_exp_f32 v46, v46
    v_exp_f32 v47, v47
    v_add_f32 v2, v40, v41
    v_add_f32 v2, v2, v42
    v_add_f32 v2, v2, v43
    v_add_f32 v2, v2, v44
    v_add_f32 v2, v2, v45
    v_add_f32 v2, v2, v46
    v_add_f32 v2, v2, v47
    v_cvt_pk_bf16_f32 v40, v40, v40
    v_cvt_pk_bf16_f32 v41, v41, v41
    v_cvt_pk_bf16_f32 v42, v42, v42
    v_cvt_pk_bf16_f32 v43, v43, v43
    v_cvt_pk_bf16_f32 v44, v44, v44
    v_cvt_pk_bf16_f32 v45, v45, v45
    v_cvt_pk_bf16_f32 v46, v46, v46
    v_cvt_pk_bf16_f32 v47, v47, v47
    v_add_f32_dpp v13, v2, v2 row_ror:8 row_mask:0xf bank_mask:0xf
    v_add_f32_dpp v52, v2, v2 row_ror:8 row_mask:0xf bank_mask:0xf
    s_nop 1
    v_permlane16_swap_b32 v13, v52
    v_add_f32 v13, v13, v52
    v_mov_b32 v52, v13
    s_nop 1
    v_permlane32_swap_b32 v13, v52
    v_add_f32 v13, v13, v52
    s_lshl_b32 s3, s70, 4
    s_add_u32 s3, s3, 1280
    v_mov_b32 v52, s3
    s_mov_b64 exec, 1
    ds_write_b64 v52, v[12:13]
    ds_add_u32 v3, v0 offset:44
    s_mov_b64 exec, -1
    s_waitcnt vmcnt(2)
    buffer_load_dwordx4 v[68:71], v9, s[36:39], s53 offen offset:512 nt
    v_and_b32 v16, v40, v4
    v_and_b32 v17, v40, v5
    v_and_b32 v18, v40, v6
    v_and_b32 v19, v40, v7
    v_and_b32 v20, v41, v4
    v_and_b32 v21, v41, v5
    v_and_b32 v22, v41, v6
    v_and_b32 v23, v41, v7
    v_and_b32 v24, v42, v4
    v_and_b32 v25, v42, v5
    v_and_b32 v26, v42, v6
    v_and_b32 v27, v42, v7
    v_lshrrev_b32 v2, 4, v1
    v_and_b32 v50, 0xf0, v9
    v_mul_u32_u24 v12, 1280, v2
    v_add_u32 v50, v50, v12
    s_lshl_b32 s3, s70, 4
    s_add_u32 s3, s3, 1408
    v_and_b32 v13, 15, v1
    v_lshlrev_b32 v13, 2, v13
    v_lshl_add_u32 v152, v2, 8, v13
    v_lshl_add_u32 v2, v2, 2, s3
    v_lshrrev_b32 v153, 1, v53
    s_and_b32 s3, s70, 3
    s_lshl_b32 s3, s3, 6
    v_add_u32 v13, s3, v153
    s_and_b32 s3, s15, 0x1ffff
    s_lshl_b32 s3, s3, 7
    v_cvt_f32_u32 v154, s3
    s_mov_b32 s8, 0x400000
L_hw:
    ds_read_b32 v52, v3 offset:36
    ds_read_b64 v[48:49], v3 offset:16
    ds_read_b32 v12, v2
    ds_read_u16 v155, v13 offset:1536
    s_waitcnt lgkmcnt(0)
    v_cmp_ne_u32 vcc, 257, v52
    s_cbranch_vccz L_hw_x
    s_sub_u32 s8, s8, 1
    s_cbranch_scc0 L_hw
L_hw_x:
    v_readfirstlane_b32 s18, v49
    v_and_b32 v144, v12, v4
    v_and_b32 v145, v12, v5
    v_and_b32 v146, v12, v6
    v_and_b32 v147, v12, v7
    v_cvt_pk_bf16_f32 v48, 0, v48
    v_mul_f32 v48, 0xbfb8aa3b, v48
    v_exp_f32 v48, v48
    s_nop 0
    v_add_f32 v48, 1.0, v48
    v_rcp_f32 v48, v48
    s_nop 0
    v_cvt_pk_bf16_f32 v48, 0, v48
    v_sub_f32 v49, 1.0, v48
    v_cvt_pk_bf16_f32 v49, 0, v49
    v_lshlrev_b32 v155, 16, v155
    v_mul_f32 v155, v155, v49
    s_branch L_part2
.p2align 12
L_wp4:
    s_branch L_back
L_part2:
    s_waitcnt vmcnt(2)
    buffer_load_dwordx4 v[72:75], v9, s[36:39], s54 offen offset:0 nt
    v_mfma_f32_16x16x32_bf16 v[28:31], v[16:19], v[156:159], 0
    v_mfma_f32_16x16x32_bf16 v[32:35], v[16:19], v[160:163], 0
    v_mfma_f32_16x16x32_bf16 v[36:39], v[16:19], v[164:167], 0
    v_and_b32 v16, v43, v4
    v_and_b32 v17, v43, v5
    v_and_b32 v18, v43, v6
    v_and_b32 v19, v43, v7
    s_waitcnt vmcnt(2)
    buffer_load_dwordx4 v[76:79], v9, s[36:39], s54 offen offset:256 nt
    s_waitcnt vmcnt(2)
    buffer_load_dwordx4 v[80:83], v9, s[36:39], s54 offen offset:512 nt
    v_mfma_f32_16x16x32_bf16 v[28:31], v[20:23], v[60:63], v[28:31]
    v_mfma_f32_16x16x32_bf16 v[32:35], v[20:23], v[64:67], v[32:35]
    v_mfma_f32_16x16x32_bf16 v[36:39], v[20:23], v[68:71], v[36:39]
    v_and_b32 v20, v44, v4
    v_and_b32 v21, v44, v5
    v_and_b32 v22, v44, v6
    v_and_b32 v23, v44, v7
    s_waitcnt vmcnt(2)
    buffer_load_dwordx4 v[84:87], v9, s[36:39], s55 offen offset:0 nt
    s_waitcnt vmcnt(2)
    buffer_load_dwordx4 v[88:91], v9, s[36:39], s55 offen offset:256 nt
    s_waitcnt vmcnt(2)
    buffer_load_dwordx4 v[92:95], v9, s[36:39], s55 offen offset:512 nt
    v_mfma_f32_16x16x32_bf16 v[28:31], v[24:27], v[72:75], v[28:31]
    v_mfma_f32_16x16x32_bf16 v[32:35], v[24:27], v[76:79], v[32:35]
    v_mfma_f32_16x16x32_bf16 v[36:39], v[24:27], v[80:83], v[36:39]
    v_and_b32 v24, v45, v4
    v_and_b32 v25, v45, v5
    v_and_b32 v26, v45, v6
    v_and_b32 v27, v45, v7
    s_waitcnt vmcnt(2)
    buffer_load_dwordx4 v[96:99], v9, s[36:39], s56 offen offset:0 nt
    s_waitcnt vmcnt(2)
    buffer_load_dwordx4 v[100:103], v9, s[36:39], s56 offen offset:256 nt
    s_waitcnt vmcnt(2)
    buffer_load_dwordx4 v[104:107], v9, s[36:39], s56 offen offset:512 nt
    v_mfma_f32_16x16x32_bf16 v[28:31], v[16:19], v[84:87], v[28:31]
    v_mfma_f32_16x16x32_bf16 v[32:35], v[16:19], v[88:91], v[32:35]
    v_mfma_f32_16x16x32_bf16 v[36:39], v[16:19], v[92:95], v[36:39]
    v_and_b32 v16, v46, v4
    v_and_b32 v17, v46, v5
    v_and_b32 v18, v46, v6
    v_and_b32 v19, v46, v7
    s_waitcnt vmcnt(2)
    buffer_load_dwordx4 v[108:111], v9, s[36:39], s57 offen offset:0 nt
    s_waitcnt vmcnt(2)
    buffer_load_dwordx4 v[112:115], v9, s[36:39], s57 offen offset:256 nt
    s_waitcnt vmcnt(2)
    buffer_load_dwordx4 v[116:119], v9, s[36:39], s57 offen offset:512 nt
    v_mfma_f32_16x16x32_bf16 v[28:31], v[20:23], v[96:99], v[28:31]
    v_mfma_f32_16x16x32_bf16 v[32:35], v[20:23], v[100:103], v[32:35]
    v_mfma_f32_16x16x32_bf16 v[36:39], v[20:23], v[104:107], v[36:39]
    v_and_b32 v20, v47, v4
    v_and_b32 v21, v47, v5
    v_and_b32 v22, v47, v6
    v_and_b32 v23, v47, v7
    s_waitcnt vmcnt(2)
    buffer_load_dwordx4 v[120:123], v9, s[36:39], s58 offen offset:0 nt
    s_waitcnt vmcnt(2)
    buffer_load_dwordx4 v[124:127], v9, s[36:39], s58 offen offset:256 nt
    s_waitcnt vmcnt(2)
    buffer_load_dwordx4 v[128:131], v9, s[36:39], s58 offen offset:512 nt
    v_mfma_f32_16x16x32_bf16 v[28:31], v[24:27], v[108:111], v[28:31]
    v_mfma_f32_16x16x32_bf16 v[32:35], v[24:27], v[112:115], v[32:35]
    v_mfma_f32_16x16x32_bf16 v[36:39], v[24:27], v[116:119], v[36:39]
    s_waitcnt vmcnt(2)
    buffer_load_dwordx4 v[132:135], v9, s[36:39], s59 offen offset:0 nt
    s_waitcnt vmcnt(2)
    buffer_load_dwordx4 v[136:139], v9, s[36:39], s59 offen offset:256 nt
    s_waitcnt vmcnt(2)
    buffer_load_dwordx4 v[140:143], v9, s[36:39], s59 offen offset:512 nt
    v_mfma_f32_16x16x32_bf16 v[28:31], v[16:19], v[120:123], v[28:31]
    v_mfma_f32_16x16x32_bf16 v[32:35], v[16:19], v[124:127], v[32:35]
    v_mfma_f32_16x16x32_bf16 v[36:39], v[16:19], v[128:131], v[36:39]
    s_mov_b32 s8, 0x400000
L_fw:
    ds_read_b32 v52, v3 offset:48
    ds_read_b32 v2, v54 offset:64
    s_waitcnt lgkmcnt(0)
    v_cmp_eq_u32 vcc, 0, v52
    s_cbranch_vccz L_fw_x
    s_sub_u32 s8, s8, 1
    s_cbranch_scc0 L_fw
L_fw_x:
    s_mov_b64 exec, 1
    ds_add_u32 v3, v0 offset:52
    s_mov_b64 exec, -1
    s_mov_b32 s8, 0x400000
L_vw:
    ds_read_b32 v52, v3 offset:52
    s_waitcnt lgkmcnt(0)
    v_cmp_gt_u32 vcc, 8, v52
    s_cbranch_vccz L_vw_x
    s_sub_u32 s8, s8, 1
    s_cbranch_scc0 L_vw
L_vw_x:
    buffer_load_dwordx4 v[60:63], v50, s[44:47], 0 offen nt
    buffer_load_dwordx4 v[64:67], v50, s[40:43], 0 offen nt
    buffer_load_dwordx4 v[68:71], v50, s[40:43], s13 offen nt
    buffer_load_dwordx4 v[72:75], v50, s[40:43], s16 offen nt
    s_waitcnt vmcnt(6)
    v_mfma_f32_16x16x32_bf16 v[28:31], v[20:23], v[132:135], v[28:31]
    s_waitcnt vmcnt(5)
    v_mfma_f32_16x16x32_bf16 v[32:35], v[20:23], v[136:139], v[32:35]
    s_waitcnt vmcnt(4)
    v_mfma_f32_16x16x32_bf16 v[36:39], v[20:23], v[140:143], v[36:39]
    s_nop 2
    s_mov_b32 exec_lo, -1
    s_mov_b32 exec_hi, 0
    ds_write_b128 v10, v[28:31] offset:0
    s_mov_b32 exec_lo, 0x00ff00ff
    s_mov_b32 exec_hi, 0xff00ff00
    ds_write_b128 v10, v[32:35] offset:512
    s_mov_b32 exec_lo, 0
    s_mov_b32 exec_hi, -1
    ds_write_b128 v10, v[36:39] offset:1024
    s_mov_b64 exec, -1
    s_waitcnt lgkmcnt(0)
    s_barrier
    ds_read_b128 v[156:159], v56
    ds_read_b128 v[160:163], v56 offset:768
    s_mov_b32 s8, 0x40000
    s_cmp_eq_u32 s18, 1
    s_waitcnt lgkmcnt(0)
    v_pk_add_f32 v[156:157], v[156:157], v[160:161]
    v_pk_add_f32 v[158:159], v[158:159], v[162:163]
    v_pk_mul_f32 v[156:157], v[156:157], v[2:3] op_sel_hi:[1,0]
    v_pk_mul_f32 v[158:159], v[158:159], v[2:3] op_sel_hi:[1,0]
    s_nop 1
    v_permlane16_swap_b32 v156, v157
    v_permlane16_swap_b32 v158, v159
    v_add_f32 v156, v156, v157
    v_add_f32 v158, v158, v159
    s_nop 1
    v_permlane32_swap_b32 v156, v158
    v_add_f32 v156, v156, v158
    s_nop 1
    v_add_f32_dpp v156, v156, v156 row_ror:8 row_mask:0xf bank_mask:0xf
    s_mov_b32 exec_lo, 0x003f003f
    s_mov_b32 exec_hi, 0x003f003f
    v_bfi_b32 v156, v11, v59, v156
    s_cbranch_scc0 L_pslow
    buffer_store_dword v156, v53, s[48:51], s100 offen
L_pdone:
    s_mov_b64 exec, -1
    s_cmp_lt_u32 s69, 30
    s_cbranch_scc0 L_fin
    s_barrier
    buffer_load_dwordx4 v[76:79], v50, s[40:43], s17 offen nt
    s_waitcnt vmcnt(5)
    v_mfma_f32_16x16x32_bf16 v[148:151], v[144:147], v[60:63], 0
    s_nop 7
    v_mul_f32 v148, v148, v49
    v_mul_f32 v149, v149, v49
    v_mul_f32 v150, v150, v49
    v_mul_f32 v151, v151, v49
    s_waitcnt vmcnt(1)
    s_branch L_h1poll
L_wp5:
    s_branch L_back
L_pslow:
    buffer_store_dword v156, v53, s[48:51], s100 offen sc1
    s_branch L_pdone
L_h1poll:
    buffer_load_dwordx4 v[12:15], v58, s[48:51], s9 offen sc1
L_h1chk:
    s_waitcnt vmcnt(0)
    v_xor_b32 v12, s76, v12
    v_xor_b32 v13, s77, v13
    v_xor_b32 v14, s78, v14
    v_xor_b32 v15, s79, v15
    v_or3_b32 v2, v12, v13, v14
    v_bitop3_b32 v2, v2, v15, v11 bitop3:0xa8
    v_cmp_ne_u32 vcc, 0, v2
    s_cbranch_vccz L_h1poll_x
    s_sub_u32 s8, s8, 1
    s_cbranch_scc0 L_h1poll
L_h1poll_x:
    v_permlane16_swap_b32 v12, v13
    v_permlane16_swap_b32 v14, v15
    v_add_f32 v12, v12, v13
    v_add_f32 v14, v14, v15
    s_nop 1
    v_permlane32_swap_b32 v12, v14
    v_add_f32 v12, v12, v14
    s_nop 1
    v_add_f32_dpp v12, v12, v12 row_ror:8 row_mask:0xf bank_mask:0xf
    v_cvt_pk_bf16_f32 v12, v12, v12
    s_nop 1
    v_and_b32_dpp v84, v12, v4 row_newbcast:0 row_mask:0xf bank_mask:0xf
    v_and_b32_dpp v85, v12, v5 row_newbcast:0 row_mask:0xf bank_mask:0xf
    v_and_b32_dpp v86, v12, v6 row_newbcast:0 row_mask:0xf bank_mask:0xf
    v_and_b32_dpp v87, v12, v7 row_newbcast:0 row_mask:0xf bank_mask:0xf
    v_and_b32_dpp v88, v12, v4 row_newbcast:1 row_mask:0xf bank_mask:0xf
    v_and_b32_dpp v89, v12, v5 row_newbcast:1 row_mask:0xf bank_mask:0xf
    v_and_b32_dpp v90, v12, v6 row_newbcast:1 row_mask:0xf bank_mask:0xf
    v_and_b32_dpp v91, v12, v7 row_newbcast:1 row_mask:0xf bank_mask:0xf
    v_mfma_f32_16x16x32_bf16 v[28:31], v[84:87], v[64:67], 0
    v_and_b32_dpp v92, v12, v4 row_newbcast:2 row_mask:0xf bank_mask:0xf
    v_and_b32_dpp v93, v12, v5 row_newbcast:2 row_mask:0xf bank_mask:0xf
    v_and_b32_dpp v94, v12, v6 row_newbcast:2 row_mask:0xf bank_mask:0xf
    v_and_b32_dpp v95, v12, v7 row_newbcast:2 row_mask:0xf bank_mask:0xf
    v_mfma_f32_16x16x32_bf16 v[28:31], v[88:91], v[68:71], v[28:31]
    v_and_b32_dpp v96, v12, v4 row_newbcast:3 row_mask:0xf bank_mask:0xf
    v_and_b32_dpp v97, v12, v5 row_newbcast:3 row_mask:0xf bank_mask:0xf
    v_and_b32_dpp v98, v12, v6 row_newbcast:3 row_mask:0xf bank_mask:0xf
    v_and_b32_dpp v99, v12, v7 row_newbcast:3 row_mask:0xf bank_mask:0xf
    v_mfma_f32_16x16x32_bf16 v[28:31], v[92:95], v[72:75], v[28:31]
    s_nop 0
    v_mfma_f32_16x16x32_bf16 v[28:31], v[96:99], v[76:79], v[28:31]
    s_mov_b32 exec_hi, 0
    s_nop 6
    v_pk_fma_f32 v[28:29], v[28:29], v[48:49], v[148:149] op_sel_hi:[1,0,1]
    v_pk_fma_f32 v[30:31], v[30:31], v[48:49], v[150:151] op_sel_hi:[1,0,1]
    ds_write_b128 v55, v[28:31]
    s_mov_b64 exec, -1
    s_cmp_lt_u32 s70, 4
    s_waitcnt lgkmcnt(0)
    s_barrier
    s_cbranch_scc0 L_fin
    ds_read_b128 v[156:159], v57
    s_mov_b32 s8, 0x40000
    s_waitcnt lgkmcnt(0)
    v_permlane16_swap_b32 v156, v157
    v_permlane16_swap_b32 v158, v159
    v_add_f32 v156, v156, v157
    v_add_f32 v158, v158, v159
    s_nop 1
    v_permlane32_swap_b32 v156, v158
    v_add_f32 v156, v156, v158
    s_nop 1
    v_add_f32_dpp v156, v156, v156 row_ror:8 row_mask:0xf bank_mask:0xf
    s_mov_b32 exec_lo, 0x01ff01ff
    s_mov_b32 exec_hi, 0x01ff01ff
L_at:
    v_cndmask_b32 v157, v156, 1.0, s[60:61]
    buffer_atomic_add_f32 v157, v152, s[48:51], s12 offen sc0
    v_add_f32 v158, v156, v155
    s_mov_b64 s[62:63], exec
    s_waitcnt vmcnt(0)
    v_sub_f32_dpp v159, v157, v154 row_newbcast:8 row_mask:0xf bank_mask:0xf
    v_add_f32 v158, v158, v157
    v_cmp_eq_f32 vcc, 0x423c0000, v159
    v_cvt_pk_bf16_f32 v158, v158, v158
    s_andn2_b64 exec, vcc, s[60:61]
    buffer_store_short v158, v153, s[64:67], s19 offen
    s_bitcmp1_b32 vcc_lo, 0
    s_cselect_b32 s3, s19, 1
    s_cmp_lg_u32 s3, 0
    s_cbranch_scc1 L_noep
    s_mov_b64 exec, 1
    v_mov_b32 v2, 0
    v_mov_b32 v52, s15
    buffer_store_dword v52, v2, s[48:51], 0 offen
L_noep:
    s_mov_b64 exec, s[62:63]
    v_cmp_nle_f32 vcc, 0, v159
    v_mov_b32 v2, 0x42400000
    v_cmp_ngt_f32 s[62:63], v2, v159
    s_or_b64 exec, vcc, s[62:63]
    s_cbranch_execz L_fin
L_atw:
    buffer_load_dword v157, v152, s[48:51], s12 offen sc1
    s_waitcnt vmcnt(0)
    v_sub_f32_dpp v159, v157, v154 row_newbcast:8 row_mask:0xf bank_mask:0xf
    v_cmp_nle_f32 vcc, 0, v159
    v_cmp_ngt_f32 s[62:63], v2, v159
    s_sub_u32 s8, s8, 1
    s_cbranch_scc1 L_fin
    s_or_b64 vcc, vcc, s[62:63]
    s_cbranch_scc1 L_atw
    s_branch L_at
L_fin:
    s_endpgm
L_wp0:
    s_branch L_back
L_service:
    s_getreg_b32 s10, hwreg(HW_REG_XCC_ID)
    s_add_u32 s70, s72, 8
    v_and_b32 v2, 1, v1
    v_lshlrev_b32 v2, 4, v2
    v_mov_b32 v3, 0xffff
    v_lshlrev_b32 v2, v2, v3
    v_bfe_u32 v3, v1, 1, 2
    v_cmp_eq_u32 vcc, 0, v3
    s_nop 1
    v_cndmask_b32 v4, 0, v2, vcc
    v_cmp_eq_u32 vcc, 1, v3
    s_nop 1
    v_cndmask_b32 v5, 0, v2, vcc
    v_cmp_eq_u32 vcc, 2, v3
    s_nop 1
    v_cndmask_b32 v6, 0, v2, vcc
    v_cmp_eq_u32 vcc, 3, v3
    s_nop 1
    v_cndmask_b32 v7, 0, v2, vcc
    s_mul_i32 s3, s70, 1536
    s_add_u32 s3, s3, 1792
    v_and_b32 v2, 16, v1
    v_lshl_add_u32 v55, v52, 5, v2
    v_add_u32 v10, s3, v55
    v_mov_b32 v3, 1152
    v_mov_b32 v0, 1
    s_mov_b32 s48, s30
    s_mov_b32 s49, s31
    s_mov_b32 s50, 548864
    s_mov_b32 s51, 0x20000
    s_mul_i32 s28, s69, 52
    s_lshr_b32 s28, s28, 8
    s_mul_i32 s29, s28, 5
    s_sub_u32 s29, s69, s29
    s_min_u32 s28, s28, 5
    s_mul_i32 s3, s68, 192
    s_lshl_b32 s101, s28, 5
    s_add_u32 s3, s3, s101
    s_mov_b32 s64, s18
    s_mov_b32 s65, s19
    s_movk_i32 s66, 3072
    s_mov_b32 s67, 0x20000
    v_and_b32 v2, 7, v1
    v_lshl_add_u32 v138, v2, 2, v53
    v_add_lshl_u32 v2, v138, s3, 1
    buffer_load_ushort v132, v2, s[64:67], 0 offen
    s_mov_b32 s60, s22
    s_mov_b32 s61, s23
    s_lshl_b32 s3, s29, 8
    v_lshlrev_b32 v8, 2, v1
    buffer_load_dword v136, v8, s[60:63], s3 offen
    v_lshlrev_b32 v2, 3, v52
    v_lshl_add_u32 v133, v53, 8, v2
    v_lshlrev_b32 v53, 4, v1
    v_mov_b32 v11, 0x1ff
    s_waitcnt lgkmcnt(0)
    s_mul_i32 s15, s14, 0x9e3779b1
    s_add_u32 s15, s15, 0x7f4a7c15
    s_or_b32 s15, s15, 0x01010101
    s_xor_b32 s15, s15, s14
    s_mov_b32 s76, s15
    s_lshr_b32 s77, s76, 8
    s_lshr_b32 s78, s76, 16
    s_lshr_b32 s79, s76, 24
    s_lshl_b32 s11, s15, 12
    s_or_b32 s11, s11, s79
    s_and_b32 s3, s10, 15
    s_lshl_b32 s3, s3, 8
    s_or_b32 s11, s11, s3
    s_and_b32 s15, s76, 0x1ffff
    s_lshl_b32 s15, s15, 7
    s_and_b32 s76, s76, 0xff
    s_bfe_u32 s3, s10, 65536
    s_lshl_b32 s3, s3, 8
    s_or_b32 s76, s76, s3
    s_and_b32 s77, s77, 0xff
    s_bfe_u32 s3, s10, 65537
    s_lshl_b32 s3, s3, 8
    s_or_b32 s77, s77, s3
    s_and_b32 s78, s78, 0xff
    s_bfe_u32 s3, s10, 65538
    s_lshl_b32 s3, s3, 8
    s_or_b32 s78, s78, s3
    s_and_b32 s79, s79, 0xff
    s_bfe_u32 s3, s10, 65539
    s_lshl_b32 s3, s3, 8
    s_or_b32 s79, s79, s3
    s_waitcnt vmcnt(2)
    v_lshl_or_b32 v124, v124, 16, v124
    v_lshl_or_b32 v125, v125, 16, v125
    v_lshl_or_b32 v126, v126, 16, v126
    v_lshl_or_b32 v127, v127, 16, v127
    v_and_b32 v108, v124, v4
    v_and_b32 v109, v124, v5
    v_and_b32 v110, v124, v6
    v_and_b32 v111, v124, v7
    v_and_b32 v112, v125, v4
    v_and_b32 v113, v125, v5
    v_and_b32 v114, v125, v6
    v_and_b32 v115, v125, v7
    v_and_b32 v116, v126, v4
    v_and_b32 v117, v126, v5
    v_and_b32 v118, v126, v6
    v_and_b32 v119, v126, v7
    v_and_b32 v120, v127, v4
    v_and_b32 v121, v127, v5
    v_and_b32 v122, v127, v6
    v_and_b32 v123, v127, v7
    v_mfma_f32_16x16x32_bf16 v[28:31], v[108:111], v[60:63], 0
    v_mfma_f32_16x16x32_bf16 v[32:35], v[108:111], v[64:67], 0
    v_mfma_f32_16x16x32_bf16 v[36:39], v[108:111], v[68:71], 0
    v_mfma_f32_16x16x32_bf16 v[28:31], v[112:115], v[72:75], v[28:31]
    v_mfma_f32_16x16x32_bf16 v[32:35], v[112:115], v[76:79], v[32:35]
    v_mfma_f32_16x16x32_bf16 v[36:39], v[112:115], v[80:83], v[36:39]
    v_mfma_f32_16x16x32_bf16 v[28:31], v[116:119], v[84:87], v[28:31]
    v_mfma_f32_16x16x32_bf16 v[32:35], v[116:119], v[88:91], v[32:35]
    v_mfma_f32_16x16x32_bf16 v[36:39], v[116:119], v[92:95], v[36:39]
    v_mfma_f32_16x16x32_bf16 v[28:31], v[120:123], v[96:99], v[28:31]
    v_mfma_f32_16x16x32_bf16 v[32:35], v[120:123], v[100:103], v[32:35]
    v_mfma_f32_16x16x32_bf16 v[36:39], v[120:123], v[104:107], v[36:39]
    v_lshlrev_b32 v12, 16, v128
    v_and_b32 v128, 0xffff0000, v128
    v_lshlrev_b32 v13, 16, v129
    v_and_b32 v129, 0xffff0000, v129
    v_lshlrev_b32 v14, 16, v130
    v_and_b32 v130, 0xffff0000, v130
    v_lshlrev_b32 v15, 16, v131
    v_and_b32 v131, 0xffff0000, v131
    s_mov_b32 exec_lo, -1
    s_mov_b32 exec_hi, 0
    ds_write_b128 v10, v[28:31] offset:0
    s_mov_b32 exec_lo, 0x00ff00ff
    s_mov_b32 exec_hi, 0xff00ff00
    ds_write_b128 v10, v[32:35] offset:512
    s_mov_b32 exec_lo, 0
    s_mov_b32 exec_hi, -1
    ds_write_b128 v10, v[36:39] offset:1024
    s_mov_b64 exec, -1
    v_pk_mul_f32 v[12:13], v[12:13], v[14:15]
    v_pk_mul_f32 v[128:129], v[128:129], v[130:131]
    v_cvt_pk_bf16_f32 v12, 0, v12
    v_cvt_pk_bf16_f32 v13, 0, v13
    v_cvt_pk_bf16_f32 v128, 0, v128
    v_cvt_pk_bf16_f32 v129, 0, v129
    v_pk_add_f32 v[12:13], v[12:13], v[128:129]
    v_add_f32 v2, v12, v13
    s_nop 1
    v_add_f32_dpp v2, v2, v2 row_ror:1 row_mask:0xf bank_mask:0xf
    s_nop 1
    v_add_f32_dpp v2, v2, v2 row_ror:2 row_mask:0xf bank_mask:0xf
    s_nop 1
    v_add_f32_dpp v2, v2, v2 row_ror:4 row_mask:0xf bank_mask:0xf
    s_nop 1
    v_add_f32_dpp v2, v2, v2 row_ror:8 row_mask:0xf bank_mask:0xf
    s_mov_b32 exec_lo, 0x00010001
    s_mov_b32 exec_hi, 0x00010001
    ds_add_f32 v3, v2 offset:16
    s_mov_b64 exec, 1
    ds_add_u32 v3, v0 offset:32
    s_mov_b64 exec, -1
    s_cmp_eq_u32 s72, 0
    s_cbranch_scc1 L_in
    s_cmp_eq_u32 s72, 2
    s_cbranch_scc1 L_pw
    s_cmp_eq_u32 s72, 3
    s_cbranch_scc1 L_pf
    s_branch L_wq1
L_wp1:
    s_branch L_back
L_wq1:
L_gq:
    s_mov_b32 s8, 0x400000
L_aw1:
    ds_read_b32 v12, v3 offset:32
    s_waitcnt lgkmcnt(0)
    v_cmp_ne_u32 vcc, 4, v12
    s_cbranch_vccz L_aw1_x
    s_sub_u32 s8, s8, 1
    s_cbranch_scc0 L_aw1
L_aw1_x:
    v_add_u32 v2, 14080, v8
    ds_read2st64_b32 v[92:93], v2 offset0:0 offset1:1
    ds_read2st64_b32 v[94:95], v2 offset0:2 offset1:3
    ds_read2st64_b32 v[96:97], v2 offset0:4 offset1:5
    ds_read2st64_b32 v[98:99], v2 offset0:6 offset1:7
    ds_read2st64_b32 v[100:101], v2 offset0:8 offset1:9
    ds_read2st64_b32 v[102:103], v2 offset0:10 offset1:11
    ds_read2st64_b32 v[104:105], v2 offset0:12 offset1:13
    ds_read2st64_b32 v[106:107], v2 offset0:14 offset1:15
    ds_read2st64_b32 v[108:109], v2 offset0:16 offset1:17
    s_lshl_b32 s3, s73, 13
    s_add_u32 s3, s3, 266240
    s_add_u32 s4, s3, 4096
    s_lshl_b32 s9, s74, 10
    s_add_u32 s9, s9, s3
    s_waitcnt lgkmcnt(0)
    v_add_f32 v92, v92, v95
    v_add_f32 v93, v93, v96
    v_add_f32 v94, v94, v97
    v_add_f32 v92, v92, v98
    v_add_f32 v93, v93, v99
    v_add_f32 v94, v94, v100
    v_add_f32 v92, v92, v101
    v_add_f32 v93, v93, v102
    v_add_f32 v94, v94, v103
    v_add_f32 v92, v92, v104
    v_add_f32 v93, v93, v105
    v_add_f32 v94, v94, v106
    v_add_f32 v92, v92, v107
    v_add_f32 v93, v93, v108
    v_add_f32 v94, v94, v109
    v_mov_b32 v95, s11
    buffer_store_dwordx4 v[92:95], v53, s[48:51], s9 offen
    s_mov_b32 s8, 0x400000
L_p1w:
    ds_read_b32 v12, v3 offset:40
    s_waitcnt lgkmcnt(0)
    v_cmp_eq_u32 vcc, 0, v12
    s_cbranch_vccz L_p1w_x
    s_sub_u32 s8, s8, 1
    s_cbranch_scc0 L_p1w
L_p1w_x:
    s_mov_b32 s8, 0x40000
L_qpoll:
    buffer_load_dwordx4 v[60:63], v53, s[48:51], s3 offen offset:0 sc1
    buffer_load_dwordx4 v[64:67], v53, s[48:51], s3 offen offset:1024 sc1
    buffer_load_dwordx4 v[68:71], v53, s[48:51], s3 offen offset:2048 sc1
    buffer_load_dwordx4 v[72:75], v53, s[48:51], s3 offen offset:3072 sc1
    buffer_load_dwordx4 v[76:79], v53, s[48:51], s4 offen offset:0 sc1
    buffer_load_dwordx4 v[80:83], v53, s[48:51], s4 offen offset:1024 sc1
    buffer_load_dwordx4 v[84:87], v53, s[48:51], s4 offen offset:2048 sc1
    buffer_load_dwordx4 v[88:91], v53, s[48:51], s4 offen offset:3072 sc1
    s_waitcnt vmcnt(0)
    v_xor_b32 v12, s11, v63
    v_bitop3_b32 v12, v12, v67, s11 bitop3:0xf6
    v_bitop3_b32 v12, v12, v71, s11 bitop3:0xf6
    v_bitop3_b32 v12, v12, v75, s11 bitop3:0xf6
    v_bitop3_b32 v12, v12, v79, s11 bitop3:0xf6
    v_bitop3_b32 v12, v12, v83, s11 bitop3:0xf6
    v_bitop3_b32 v12, v12, v87, s11 bitop3:0xf6
    v_bitop3_b32 v12, v12, v91, s11 bitop3:0xf6
    v_and_b32 v2, 0xfffff0ff, v12
    v_cmp_ne_u32 vcc, 0, v2
    s_cbranch_vccz L_qpoll_x
    s_cmp_lg_u32 s8, 262141
    s_cbranch_scc1 L_qpoll_n
    s_mov_b64 s[34:35], exec
    s_mov_b32 exec_lo, -1
    s_mov_b32 exec_hi, -1
    buffer_store_dwordx4 v[92:95], v53, s[48:51], s9 offen sc1
    s_mov_b64 exec, s[34:35]
L_qpoll_n:
    s_sub_u32 s8, s8, 1
    s_cbranch_scc0 L_qpoll
L_qpoll_x:
    v_cmp_ne_u32 vcc, 0, v12
    v_pk_add_f32 v[60:61], v[60:61], v[64:65]
    v_add_f32 v62, v62, v66
    v_pk_add_f32 v[68:69], v[68:69], v[72:73]
    v_add_f32 v70, v70, v74
    v_pk_add_f32 v[76:77], v[76:77], v[80:81]
    v_add_f32 v78, v78, v82
    v_pk_add_f32 v[84:85], v[84:85], v[88:89]
    v_add_f32 v86, v86, v90
    v_pk_add_f32 v[60:61], v[60:61], v[68:69]
    v_add_f32 v62, v62, v70
    v_pk_add_f32 v[76:77], v[76:77], v[84:85]
    v_add_f32 v78, v78, v86
    v_pk_add_f32 v[60:61], v[60:61], v[76:77]
    v_add_f32 v62, v62, v78
    v_cvt_pk_bf16_f32 v60, v60, v61
    v_cvt_pk_bf16_f32 v62, v62, v62
    v_lshlrev_b32 v2, 1, v1
    ds_write_b16 v2, v60 offset:384
    ds_write_b16_d16_hi v2, v60 offset:512
    ds_write_b16 v2, v62 offset:640
    s_cbranch_vccz L_qsame
    buffer_store_dwordx4 v[92:95], v53, s[48:51], s9 offen sc1
    s_waitcnt vmcnt(0)
L_qsame:
    v_mov_b32 v52, 0x100
    s_mov_b64 exec, 1
    ds_add_u32 v3, v52 offset:36
    s_mov_b64 exec, -1
    s_endpgm
L_wp2:
    s_branch L_back
L_pf:
    s_mov_b32 exec_hi, 0xffffff
    ds_read_b128 v[92:95], v53 offset:18688
    ds_read_b128 v[96:99], v53 offset:19456
    s_lshl_b32 s3, s68, 15
    s_add_u32 s3, s3, 4096
    s_lshl_b32 s9, s69, 10
    s_add_u32 s9, s9, s3
    s_lshl_b32 s100, s28, 7
    s_add_u32 s3, s3, s100
    s_add_u32 s4, s3, 8192
    s_add_u32 s5, s3, 16384
    s_add_u32 s6, s3, 24576
    s_waitcnt lgkmcnt(0)
    v_pk_add_f32 v[92:93], v[92:93], v[96:97]
    v_pk_add_f32 v[94:95], v[94:95], v[98:99]
    v_bfi_b32 v92, v11, s76, v92
    v_bfi_b32 v93, v11, s77, v93
    v_bfi_b32 v94, v11, s78, v94
    v_bfi_b32 v95, v11, s79, v95
    buffer_store_dwordx4 v[92:95], v53, s[48:51], s9 offen
    s_mov_b64 exec, -1
    v_lshrrev_b32 v2, 3, v1
    v_and_b32 v52, 0x70, v53
    v_lshl_add_u32 v52, v2, 10, v52
    s_mov_b32 s8, 0x400000
L_p1w2:
    ds_read_b32 v12, v3 offset:40
    s_waitcnt lgkmcnt(0)
    v_cmp_eq_u32 vcc, 0, v12
    s_cbranch_vccz L_p1w2_x
    s_sub_u32 s8, s8, 1
    s_cbranch_scc0 L_p1w2
L_p1w2_x:
    s_mov_b32 s8, 0x40000
L_fpoll:
    buffer_load_dwordx4 v[60:63], v52, s[48:51], s3 offen sc1
    buffer_load_dwordx4 v[64:67], v52, s[48:51], s4 offen sc1
    buffer_load_dwordx4 v[68:71], v52, s[48:51], s5 offen sc1
    buffer_load_dwordx4 v[72:75], v52, s[48:51], s6 offen sc1
    s_waitcnt vmcnt(0)
    v_xor_b32 v12, s76, v60
    v_bitop3_b32 v12, v12, v61, s77 bitop3:0xf6
    v_bitop3_b32 v12, v12, v62, s78 bitop3:0xf6
    v_bitop3_b32 v12, v12, v63, s79 bitop3:0xf6
    v_bitop3_b32 v12, v12, v64, s76 bitop3:0xf6
    v_bitop3_b32 v12, v12, v65, s77 bitop3:0xf6
    v_bitop3_b32 v12, v12, v66, s78 bitop3:0xf6
    v_bitop3_b32 v12, v12, v67, s79 bitop3:0xf6
    v_bitop3_b32 v12, v12, v68, s76 bitop3:0xf6
    v_bitop3_b32 v12, v12, v69, s77 bitop3:0xf6
    v_bitop3_b32 v12, v12, v70, s78 bitop3:0xf6
    v_bitop3_b32 v12, v12, v71, s79 bitop3:0xf6
    v_bitop3_b32 v12, v12, v72, s76 bitop3:0xf6
    v_bitop3_b32 v12, v12, v73, s77 bitop3:0xf6
    v_bitop3_b32 v12, v12, v74, s78 bitop3:0xf6
    v_bitop3_b32 v12, v12, v75, s79 bitop3:0xf6
    v_and_b32 v2, 0xff, v12
    v_cmp_ne_u32 vcc, 0, v2
    s_cbranch_vccz L_fpoll_x
    s_cmp_lg_u32 s8, 262141
    s_cbranch_scc1 L_fpoll_n
    s_mov_b64 s[34:35], exec
    s_mov_b32 exec_lo, -1
    s_mov_b32 exec_hi, 0xffff
    buffer_store_dwordx4 v[92:95], v53, s[48:51], s9 offen sc1
    s_mov_b64 exec, s[34:35]
L_fpoll_n:
    s_sub_u32 s8, s8, 1
    s_cbranch_scc0 L_fpoll
L_fpoll_x:
    v_and_b32 v12, 0x100, v12
    v_cmp_ne_u32 vcc, 0, v12
    v_mov_b32 v13, 1
    s_cbranch_vccz L_fsame
    v_mov_b32 v13, 0
    s_mov_b32 exec_hi, 0xffff
    buffer_store_dwordx4 v[92:95], v53, s[48:51], s9 offen sc1
    s_mov_b64 exec, -1
L_fsame:
    v_bfi_b32 v60, v11, 0, v60
    v_bfi_b32 v61, v11, 0, v61
    v_bfi_b32 v62, v11, 0, v62
    v_bfi_b32 v63, v11, 0, v63
    v_bfi_b32 v64, v11, 0, v64
    v_bfi_b32 v65, v11, 0, v65
    v_bfi_b32 v66, v11, 0, v66
    v_bfi_b32 v67, v11, 0, v67
    v_bfi_b32 v68, v11, 0, v68
    v_bfi_b32 v69, v11, 0, v69
    v_bfi_b32 v70, v11, 0, v70
    v_bfi_b32 v71, v11, 0, v71
    v_bfi_b32 v72, v11, 0, v72
    v_bfi_b32 v73, v11, 0, v73
    v_bfi_b32 v74, v11, 0, v74
    v_bfi_b32 v75, v11, 0, v75
    v_pk_add_f32 v[60:61], v[60:61], v[64:65]
    v_pk_add_f32 v[62:63], v[62:63], v[66:67]
    v_pk_add_f32 v[68:69], v[68:69], v[72:73]
    v_pk_add_f32 v[70:71], v[70:71], v[74:75]
    v_pk_add_f32 v[60:61], v[60:61], v[68:69]
    v_pk_add_f32 v[62:63], v[62:63], v[70:71]
    s_nop 1
    v_permlane16_swap_b32 v60, v61
    v_permlane16_swap_b32 v62, v63
    v_add_f32 v60, v60, v61
    v_add_f32 v62, v62, v63
    s_nop 1
    v_permlane32_swap_b32 v60, v62
    v_add_f32 v60, v60, v62
    s_nop 1
    v_add_f32_dpp v60, v60, v60 row_ror:8 row_mask:0xf bank_mask:0xf
    v_lshlrev_b32 v132, 16, v132
    v_cvt_pk_bf16_f32 v60, 0, v60
    v_add_f32 v60, v60, v132
    v_cvt_pk_bf16_f32 v60, 0, v60
    v_mul_f32 v2, v60, v60
    v_mov_b32 v52, 0xc0135761
    v_fmac_f32 v52, 0xbdd2d3e8, v2
    v_mul_f32 v52, v52, v60
    v_exp_f32 v52, v52
    v_lshlrev_b32 v2, 2, v138
    v_add_f32 v52, 1.0, v52
    v_rcp_f32 v52, v52
    s_nop 0
    v_mul_f32 v60, v60, v52
    v_cvt_pk_bf16_f32 v60, v60, v60
    ds_write_b32 v2, v60 offset:1408
    ds_write_b32 v8, v136 offset:1536
    s_mov_b64 exec, 1
    ds_write_b32 v3, v13 offset:20
    s_mov_b64 exec, 1
    ds_add_u32 v3, v0 offset:36
    s_mov_b64 exec, -1
    s_endpgm
.p2align 12
L_wp3:
    s_branch L_back
L_pw:
    s_lshl_b32 s3, s68, 5
    s_and_b32 s9, s69, 24
    s_add_u32 s3, s3, s9
    s_lshl_b32 s3, s3, 10
    s_add_u32 s3, s3, 4096
    s_lshl_b32 s9, s74, 10
    s_add_u32 s9, s9, s3
    s_xor_b32 s11, s11, 2
    s_and_b32 s11, s11, 0xfffff0ff
    v_lshrrev_b32 v2, 3, v1
    v_and_b32 v8, 0x70, v53
    v_lshl_add_u32 v52, v2, 10, v8
    s_mov_b32 s8, 0x400000
L_hw2:
    ds_read_b32 v12, v3 offset:36
    ds_read_b32 v13, v3 offset:20
    s_waitcnt lgkmcnt(0)
    v_cmp_ne_u32 vcc, 257, v12
    s_cbranch_vccz L_hw2_x
    s_sub_u32 s8, s8, 1
    s_cbranch_scc0 L_hw2
L_hw2_x:
    v_readfirstlane_b32 s4, v13
    s_mov_b32 s8, 0x400000
L_mw:
    ds_read_b32 v12, v3 offset:44
    ds_read_b128 v[92:95], v8 offset:1280
    s_waitcnt lgkmcnt(0)
    v_cmp_ne_u32 vcc, 8, v12
    s_cbranch_vccz L_mw_x
    s_sub_u32 s8, s8, 1
    s_cbranch_scc0 L_mw
L_mw_x:
    v_mov_b32 v68, v92
    v_mov_b32 v95, s11
    s_mov_b64 exec, 0xff
    s_cmp_eq_u32 s4, 1
    s_waitcnt vmcnt(0)
    s_cbranch_scc1 L_sfast
    buffer_store_dwordx4 v[92:95], v53, s[48:51], s9 offen offset:768 sc1
    s_branch L_sdone
L_sfast:
    buffer_store_dwordx4 v[92:95], v53, s[48:51], s9 offen offset:768
L_sdone:
    s_mov_b64 exec, -1
    s_mov_b32 s8, 0x40000
L_spoll:
    buffer_load_dwordx4 v[60:63], v52, s[48:51], s3 offen offset:768 sc1
    s_waitcnt vmcnt(0)
    v_cmp_ne_u32 vcc, s11, v63
    s_cbranch_vccz L_spoll_x
    s_sub_u32 s8, s8, 1
    s_cbranch_scc0 L_spoll
L_spoll_x:
    v_max_f32_dpp v64, v60, v60 row_ror:8 row_mask:0xf bank_mask:0xf
    v_max_f32_dpp v2, v60, v60 row_ror:8 row_mask:0xf bank_mask:0xf
    s_nop 1
    v_permlane16_swap_b32 v64, v2
    v_max_f32 v64, v64, v2
    v_mov_b32 v2, v64
    s_nop 1
    v_permlane32_swap_b32 v64, v2
    v_max_f32 v64, v64, v2
    s_nop 1
    v_max_f32_dpp v64, v64, v64 row_ror:4 row_mask:0xf bank_mask:0xf
    s_nop 1
    v_max_f32_dpp v64, v64, v64 row_ror:2 row_mask:0xf bank_mask:0xf
    s_nop 1
    v_max_f32_dpp v64, v64, v64 row_ror:1 row_mask:0xf bank_mask:0xf
    v_sub_f32 v60, v60, v64
    v_sub_f32 v68, v68, v64
    v_exp_f32 v60, v60
    v_exp_f32 v68, v68
    v_mul_f32 v60, v60, v61
    s_nop 1
    v_add_f32_dpp v64, v60, v60 row_ror:8 row_mask:0xf bank_mask:0xf
    v_add_f32_dpp v2, v60, v60 row_ror:8 row_mask:0xf bank_mask:0xf
    s_nop 1
    v_permlane16_swap_b32 v64, v2
    v_add_f32 v64, v64, v2
    v_mov_b32 v2, v64
    s_nop 1
    v_permlane32_swap_b32 v64, v2
    v_add_f32 v64, v64, v2
    s_nop 1
    v_add_f32_dpp v64, v64, v64 row_ror:4 row_mask:0xf bank_mask:0xf
    s_nop 1
    v_add_f32_dpp v64, v64, v64 row_ror:2 row_mask:0xf bank_mask:0xf
    s_nop 1
    v_add_f32_dpp v64, v64, v64 row_ror:1 row_mask:0xf bank_mask:0xf
    v_rcp_f32 v64, v64
    v_lshrrev_b32 v8, 2, v8
    v_mul_f32 v68, v68, v64
    s_mov_b64 exec, 0xff
    ds_write_b32 v8, v68 offset:1216
    s_mov_b64 exec, 1
    ds_add_u32 v3, v0 offset:48
    s_mov_b64 exec, -1
    s_endpgm
L_in:
    s_sub_u32 s3, 255, s2
    s_cmp_lt_u32 s3, 20
    s_cbranch_scc0 L_end
    s_mov_b32 s8, 0x400000
L_p1w0:
    ds_read_b32 v12, v3 offset:40
    s_waitcnt lgkmcnt(0)
    v_cmp_eq_u32 vcc, 0, v12
    s_cbranch_vccz L_p1w0_x
    s_sub_u32 s8, s8, 1
    s_cbranch_scc0 L_p1w0
L_p1w0_x:
    v_cvt_f32_u32 v12, s15
    v_cmp_eq_u32 vcc, 4, v52
    s_lshl_b32 s3, s3, 10
    s_add_u32 s3, s3, 528384
    v_mov_b32 v13, 0
    v_cndmask_b32 v12, 0, v12, vcc
    buffer_store_dwordx2 v[12:13], v133, s[48:51], s3 offen sc1
    s_endpgm
L_end:
    s_endpgm
.section .rodata,"a"
.p2align 6
.amdhsa_kernel gated_mix__sliding_block_cached__dense_activation_gelu__decode_kernel
  .amdhsa_next_free_vgpr 168
  .amdhsa_next_free_sgpr 102
  .amdhsa_accum_offset 168
  .amdhsa_group_segment_fixed_size 0
  .amdhsa_kernarg_size 112
  .amdhsa_user_sgpr_count 2
  .amdhsa_user_sgpr_kernarg_segment_ptr 1
  .amdhsa_system_sgpr_workgroup_id_x 1
.end_amdhsa_kernel
```
